```python
import torch

def _softmax(x, axis=-1):
    return torch.softmax(x, dim=axis)
def _gelu(x):
    return torch.nn.functional.gelu(x, approximate="tanh")
def _silu(x):
    return torch.nn.functional.silu(x)
def _sigmoid(x):
    return torch.sigmoid(x)
def _layernorm(x, axis=-1, eps=1e-5):
    m = x.mean(dim=axis, keepdim=True)
    v = x.var(dim=axis, keepdim=True, unbiased=False)
    return (x - m) / torch.sqrt(v + eps)
def _scatter_add(tgt, idx, src, axis=0):
    return tgt.clone().index_add_(axis, idx, src)
def _segment_sum(src, seg, n):
    out = torch.zeros((n,) + src.shape[1:], dtype=src.dtype)
    return out.index_add_(0, seg, src)
def _pad(x, pw):
    flat = tuple(v for pair in reversed(pw) for v in pair)
    return torch.nn.functional.pad(x, flat)

kernel_name = 'standalone__low_rank_proj_linformer__sampling'

def setup_inputs():

    _w = (lambda a: (lambda t: t.to(torch.bfloat16) if t.is_floating_point() else t)(torch.as_tensor(a)))
    B, H, Sq, Skv, Dh, R = 8, 32, 8, 2048, 192, 16
    return {
        "q": _w((lambda *s: torch.randn(*s, dtype=torch.bfloat16) * 0.8)(B, H, Sq, Dh)),
        "k": _w((lambda *s: torch.randn(*s, dtype=torch.bfloat16) * 0.8)(B, H, Skv, Dh)),
        "v": _w((lambda *s: torch.randn(*s, dtype=torch.bfloat16) * 0.05)(B, H, Skv, Dh)),
        "e_proj": _w((lambda *s: torch.randn(*s, dtype=torch.bfloat16) * 0.8)(R, Skv) * (Skv ** -0.5)),
        "f_proj": _w((lambda *s: torch.randn(*s, dtype=torch.bfloat16) * 0.05)(R, Skv) * (Skv ** -0.5)),
    }

def reference(q, k, v, e_proj, f_proj):
    B, H, Sq, Dh = q.shape
    kp = torch.einsum("rn,bhnd->bhrd", e_proj, k)
    vp = torch.einsum("rn,bhnd->bhrd", f_proj, v)
    scores = torch.einsum("bhqd,bhrd->bhqr", q, kp) * (Dh ** -0.5)
    p = _softmax(scores, axis=-1)
    o = torch.einsum("bhqr,bhrd->bhqd", p, vp)
    return o
```

```asm
; @launch grid=(256,1,1) block=(256,1,1) lds=162816
.amdgcn_target "amdgcn-amd-amdhsa--gfx950"
.text
.globl standalone__low_rank_proj_linformer__sampling_kernel
.p2align 12
.p2align 8
.type standalone__low_rank_proj_linformer__sampling_kernel,@function
standalone__low_rank_proj_linformer__sampling_kernel:
  s_load_dwordx8 s[4:11], s[0:1], 0
  s_load_dwordx4 s[64:67], s[0:1], 32
  v_lshrrev_b32 v1, 6, v0
  s_cmp_ge_u32 s2, 256
  s_cbranch_scc1 L_end
  v_readfirstlane_b32 s3, v1
  v_and_b32 v0, 63, v0
  v_lshrrev_b32 v11, 4, v0
  s_bfe_u32 s33, s2, 0x20001
  s_mov_b32 s19, 0x20000
  s_mov_b32 s37, 0
  s_cmp_lg_u32 s3, 0
  s_cbranch_scc1 L_consumer
  s_setprio 3
  s_mul_i32 s40, s2, 786432
  s_mov_b32 s18, 786432
  v_and_b32 v7, 7, v0
  v_lshlrev_b32 v7, 4, v7
  v_bfe_u32 v10, v0, 3, 1
  v_mul_u32_u24 v10, 0x180, v10
  v_add_u32 v7, v7, v10
  v_and_b32 v10, 1, v11
  v_lshl_add_u32 v7, v10, 9, v7
  v_lshrrev_b32 v10, 5, v0
  v_lshl_add_u32 v7, v10, 12, v7
  s_mul_i32 s80, s33, 0x30000
  s_mov_b32 s72, 0
  s_mov_b32 s38, 0
  s_mov_b32 s41, 0xe000
  s_mov_b32 s36, 147456
  s_waitcnt lgkmcnt(0)
  s_add_u32 s16, s6, s40
  s_addc_u32 s17, s7, 0
L_half:
  s_brev_b32 s35, s38
  s_lshr_b32 s35, s35, 16
  s_and_b32 s39, s35, s41
  s_bfe_u32 s34, s35, 0x2000b
  s_lshl_b32 s34, s34, 10
  s_or_b32 s39, s39, s34
  s_add_u32 s39, s39, s80
  s_add_u32 s35, s35, s72
  s_add_u32 s38, s38, 2
  s_sub_u32 s34, s35, s36
  s_min_u32 m0, s35, s34
  s_waitcnt vmcnt(19)
  buffer_load_dwordx4 v7, s[16:19], s39 offen nt lds
  s_add_u32 s32, s39, 0x8000
  s_add_u32 s33, s35, 0x8000
  s_sub_u32 s34, s33, s36
  s_min_u32 m0, s33, s34
  s_waitcnt vmcnt(19)
  buffer_load_dwordx4 v7, s[16:19], s32 offen nt lds
  s_and_b32 s34, s38, 31
  s_cbranch_scc1 L_half
L_halfdone:
  v_xor_b32 v7, 0xc0, v7
  s_add_u32 s37, s37, 1
  s_cmp_le_u32 s37, 2
  s_cbranch_scc1 L_nobar
  s_barrier
L_nobar:
  s_bitcmp1_b32 s37, 0
  s_cbranch_scc1 L_half
  s_mov_b32 s38, 0
  s_add_u32 s72, s72, 0x10000
  s_sub_u32 s35, s72, s36
  s_min_u32 s72, s72, s35
  s_add_u32 s80, s80, 0x10000
  s_cmp_eq_u32 s80, s18
  s_cselect_b32 s80, 0, s80
  s_cmp_eq_u32 s37, 46
  s_cbranch_scc1 L_last
  s_cmp_lg_u32 s37, 24
  s_cbranch_scc1 L_half
  s_add_u32 s16, s8, s40
  s_addc_u32 s17, s9, 0
  s_branch L_half
L_last:
  v_xor_b32 v9, 0xc0, v7
  s_mov_b32 s37, 0
L_chunk:
  s_mov_b32 m0, s72
  s_waitcnt vmcnt(31)
  buffer_load_dwordx4 v7, s[16:19], s80 offen nt lds
  s_add_u32 m0, s72, 0x400
  s_waitcnt vmcnt(31)
  buffer_load_dwordx4 v9, s[16:19], s80 offen nt lds
  s_add_u32 m0, s72, 0x400
  s_waitcnt vmcnt(31)
  buffer_load_dwordx4 v7, s[16:19], s80 offen offset:1024 nt lds
  s_add_u32 m0, s72, 0x800
  s_waitcnt vmcnt(31)
  buffer_load_dwordx4 v9, s[16:19], s80 offen offset:1024 nt lds
  s_add_u32 m0, s72, 0x800
  s_waitcnt vmcnt(31)
  buffer_load_dwordx4 v7, s[16:19], s80 offen offset:2048 nt lds
  s_add_u32 m0, s72, 0xc00
  s_waitcnt vmcnt(31)
  buffer_load_dwordx4 v9, s[16:19], s80 offen offset:2048 nt lds
  s_add_u32 m0, s72, 0xc00
  s_waitcnt vmcnt(31)
  buffer_load_dwordx4 v7, s[16:19], s80 offen offset:3072 nt lds
  s_add_u32 m0, s72, 0x1000
  s_waitcnt vmcnt(31)
  buffer_load_dwordx4 v9, s[16:19], s80 offen offset:3072 nt lds
  s_add_u32 s72, s72, 0x2000
  s_sub_u32 s35, s72, s36
  s_min_u32 s72, s72, s35
  s_add_u32 s80, s80, 0x2000
  s_add_u32 s37, s37, 1
  s_cmp_lg_u32 s37, 4
  s_cbranch_scc1 L_notmid
  s_barrier
L_notmid:
  s_cmp_lg_u32 s37, 8
  s_cbranch_scc1 L_chunk
  s_barrier
  s_waitcnt vmcnt(24)
  s_barrier
  s_waitcnt vmcnt(8)
  s_barrier
  s_waitcnt vmcnt(0)
  s_barrier
  s_endpgm
L_eload:
  s_and_b32 s35, s32, 7
  s_cmp_eq_u32 s35, 0
  s_cselect_b32 s35, 2, 3
  s_cmp_le_u32 s35, s3
  s_cbranch_scc1 L_eskip
  s_cmp_ge_u32 s32, 32
  s_cselect_b32 s16, s64, s10
  s_cselect_b32 s17, s65, s11
  s_lshl_b32 s20, s3, 11
  s_add_u32 s20, s20, s33
  s_sub_u32 s21, s20, 0x3000
  s_min_u32 s20, s20, s21
  s_add_u32 m0, s20, 147456
  s_add_u32 s21, s32, s22
  s_and_b32 s21, s21, 31
  s_lshl_b32 s21, s21, 7
  buffer_load_dwordx4 v68, s[16:19], s21 offen lds
  s_add_u32 m0, m0, 0x400
  s_nop 0
  buffer_load_dwordx4 v69, s[16:19], s21 offen lds
L_eskip:
  s_add_u32 s32, s32, s35
  s_lshl_b32 s35, s35, 11
  s_add_u32 s33, s33, s35
  s_sub_u32 s35, s33, 0x3000
  s_min_u32 s33, s33, s35
  s_setpc_b64 s[60:61]
L_kbar:
  s_barrier
  s_call_b64 s[60:61], L_eload
L_k:
  ds_read_b128 v[12:15], v6
  ds_read_b64_tr_b16 v[16:17], v72
  ds_read_b64_tr_b16 v[18:19], v73
  ds_read_b64_tr_b16 v[20:21], v72 offset:8
  ds_read_b64_tr_b16 v[22:23], v73 offset:8
  ds_read_b64_tr_b16 v[24:25], v76
  ds_read_b64_tr_b16 v[26:27], v77
  ds_read_b64_tr_b16 v[28:29], v76 offset:8
  ds_read_b64_tr_b16 v[30:31], v77 offset:8
  ds_read_b128 v[80:83], v8
  ds_read_b64_tr_b16 v[84:85], v74
  ds_read_b64_tr_b16 v[86:87], v75
  ds_read_b64_tr_b16 v[88:89], v74 offset:8
  ds_read_b64_tr_b16 v[90:91], v75 offset:8
  s_waitcnt lgkmcnt(11)
  v_mfma_f32_16x16x32_bf16 v[32:35], v[16:19], v[12:15], v[32:35]
  ds_read_b64_tr_b16 v[92:93], v78
  ds_read_b64_tr_b16 v[94:95], v79
  s_waitcnt lgkmcnt(11)
  v_mfma_f32_16x16x32_bf16 v[36:39], v[20:23], v[12:15], v[36:39]
  ds_read_b64_tr_b16 v[96:97], v78 offset:8
  ds_read_b64_tr_b16 v[98:99], v79 offset:8
  s_add_u32 s34, s34, 0x6000
  s_add_u32 s36, s36, 0x800
  s_cmp_eq_u32 s36, 0x3000
  s_cselect_b32 s34, 0, s34
  s_cselect_b32 s36, 0, s36
  s_waitcnt lgkmcnt(11)
  v_mfma_f32_16x16x32_bf16 v[40:43], v[24:27], v[12:15], v[40:43]
  s_waitcnt lgkmcnt(9)
  v_mfma_f32_16x16x32_bf16 v[44:47], v[28:31], v[12:15], v[44:47]
  s_waitcnt lgkmcnt(6)
  v_mfma_f32_16x16x32_bf16 v[32:35], v[84:87], v[80:83], v[32:35]
  s_waitcnt lgkmcnt(4)
  v_mfma_f32_16x16x32_bf16 v[36:39], v[88:91], v[80:83], v[36:39]
  s_waitcnt lgkmcnt(2)
  v_mfma_f32_16x16x32_bf16 v[40:43], v[92:95], v[80:83], v[40:43]
  s_waitcnt lgkmcnt(0)
  v_mfma_f32_16x16x32_bf16 v[44:47], v[96:99], v[80:83], v[44:47]
  v_add_u32 v72, s34, v64
  v_add_u32 v73, s34, v65
  v_add_u32 v74, s34, v66
  v_add_u32 v75, s34, v67
  v_add_u32 v6, s36, v7
  v_xor_b32 v76, 64, v72
  v_xor_b32 v77, 64, v73
  v_xor_b32 v78, 64, v74
  v_xor_b32 v79, 64, v75
  v_xor_b32 v8, 64, v6
  s_bitcmp1_b32 s38, s37
  s_cbranch_scc1 L_kend
  s_add_u32 s37, s37, 1
  s_branch L_k
L_kend:
  s_cmp_eq_u32 s37, 31
  s_cbranch_scc1 L_kdone
  s_waitcnt vmcnt(0)
  s_barrier
  s_bitcmp1_b32 s39, s37
  s_cbranch_scc1 L_ktwo
  s_add_u32 s37, s37, 1
  s_branch L_k
L_ktwo:
  s_add_u32 s37, s37, 1
  s_branch L_kbar
L_kdone:
  v_cvt_pk_bf16_f32 v16, v32, v33
  v_cvt_pk_bf16_f32 v17, v34, v35
  v_cvt_pk_bf16_f32 v18, v36, v37
  v_cvt_pk_bf16_f32 v19, v38, v39
  v_cvt_pk_bf16_f32 v20, v40, v41
  v_cvt_pk_bf16_f32 v21, v42, v43
  v_cvt_pk_bf16_f32 v22, v44, v45
  v_cvt_pk_bf16_f32 v23, v46, v47
  s_mov_b32 s37, 0
  s_mov_b32 s38, 0xf2929292
  v_mfma_f32_16x16x32_bf16 v[56:59], v[16:19], v[48:51], 0
  v_mfma_f32_16x16x32_bf16 v[52:55], v[20:23], v[48:51], 0
  s_mov_b32 s39, 0x02929292
  s_mov_b32 s42, 0x3d93cd3a
  s_mov_b32 s43, 0x3fb8aa3b
  s_mov_b32 s44, 0xffff0000
  s_mov_b32 s46, 0xff00ff00
  s_mov_b32 s47, s46
  v_mov_b64 v[32:33], 0
  v_mov_b64 v[34:35], 0
  v_mov_b64 v[36:37], 0
  v_mov_b64 v[38:39], 0
  v_mov_b64 v[40:41], 0
  v_mov_b64 v[42:43], 0
  v_mov_b64 v[44:45], 0
  v_mov_b64 v[46:47], 0
  v_cndmask_b32 v56, v56, v52, s[46:47]
  v_cndmask_b32 v57, v57, v53, s[46:47]
  v_cndmask_b32 v58, v58, v54, s[46:47]
  v_cndmask_b32 v59, v59, v55, s[46:47]
  s_nop 1
  v_add_f32_dpp v56, v56, v56 row_ror:8 row_mask:0xf bank_mask:0xf
  v_add_f32_dpp v57, v57, v57 row_ror:8 row_mask:0xf bank_mask:0xf
  v_add_f32_dpp v58, v58, v58 row_ror:8 row_mask:0xf bank_mask:0xf
  v_add_f32_dpp v59, v59, v59 row_ror:8 row_mask:0xf bank_mask:0xf
  ds_write_b128 v4, v[56:59]
  s_waitcnt vmcnt(0) lgkmcnt(0)
  s_barrier
  ds_read_b128 v[48:51], v5
  ds_read_b128 v[52:55], v5 offset:1024
  ds_read_b128 v[56:59], v5 offset:2048
  s_waitcnt lgkmcnt(1)
  v_add_f32 v48, v48, v52
  v_add_f32 v49, v49, v53
  v_add_f32 v50, v50, v54
  v_add_f32 v51, v51, v55
  s_waitcnt lgkmcnt(0)
  v_add_f32 v48, v48, v56
  v_add_f32 v49, v49, v57
  v_add_f32 v50, v50, v58
  v_add_f32 v51, v51, v59
  v_cvt_pk_bf16_f32 v52, v48, v49
  v_cvt_pk_bf16_f32 v53, v50, v51
  v_lshlrev_b32 v48, 16, v52
  v_and_b32 v49, s44, v52
  v_lshlrev_b32 v50, 16, v53
  v_and_b32 v51, s44, v53
  v_mul_f32 v48, s42, v48
  v_mul_f32 v49, s42, v49
  v_mul_f32 v50, s42, v50
  v_mul_f32 v51, s42, v51
  v_cvt_pk_bf16_f32 v52, v48, v49
  v_cvt_pk_bf16_f32 v53, v50, v51
  v_lshlrev_b32 v48, 16, v52
  v_and_b32 v49, s44, v52
  v_lshlrev_b32 v50, 16, v53
  v_and_b32 v51, s44, v53
  v_max3_f32 v54, v48, v49, v50
  v_max_f32 v54, v54, v51
  v_mov_b32 v55, v54
  s_nop 1
  v_permlane16_swap_b32 v54, v55
  v_max_f32 v54, v54, v55
  v_mov_b32 v55, v54
  s_nop 1
  v_permlane32_swap_b32 v54, v55
  v_max_f32 v54, v54, v55
  v_sub_f32 v48, v48, v54
  v_sub_f32 v49, v49, v54
  v_sub_f32 v50, v50, v54
  v_sub_f32 v51, v51, v54
  v_mul_f32 v48, s43, v48
  v_mul_f32 v49, s43, v49
  v_mul_f32 v50, s43, v50
  v_mul_f32 v51, s43, v51
  v_exp_f32 v48, v48
  v_exp_f32 v49, v49
  v_exp_f32 v50, v50
  v_exp_f32 v51, v51
  s_nop 0
  v_add_f32 v54, v48, v49
  v_add_f32 v53, v50, v51
  v_add_f32 v54, v54, v53
  v_mov_b32 v55, v54
  s_nop 1
  v_permlane16_swap_b32 v54, v55
  v_add_f32 v54, v54, v55
  v_mov_b32 v55, v54
  s_nop 1
  v_permlane32_swap_b32 v54, v55
  v_add_f32 v54, v54, v55
  v_rcp_f32 v54, v54
  s_nop 0
  v_mul_f32 v48, v48, v54
  v_mul_f32 v49, v49, v54
  v_mul_f32 v50, v50, v54
  v_mul_f32 v51, v51, v54
  v_cvt_pk_bf16_f32 v60, v48, v49
  v_cvt_pk_bf16_f32 v61, v50, v51
L_vbar:
  s_barrier
  s_call_b64 s[60:61], L_eload
L_v:
  ds_read_b128 v[12:15], v6
  ds_read_b64_tr_b16 v[16:17], v72
  ds_read_b64_tr_b16 v[18:19], v73
  ds_read_b64_tr_b16 v[20:21], v72 offset:8
  ds_read_b64_tr_b16 v[22:23], v73 offset:8
  ds_read_b64_tr_b16 v[24:25], v76
  ds_read_b64_tr_b16 v[26:27], v77
  ds_read_b64_tr_b16 v[28:29], v76 offset:8
  ds_read_b64_tr_b16 v[30:31], v77 offset:8
  ds_read_b128 v[80:83], v8
  ds_read_b64_tr_b16 v[84:85], v74
  ds_read_b64_tr_b16 v[86:87], v75
  ds_read_b64_tr_b16 v[88:89], v74 offset:8
  ds_read_b64_tr_b16 v[90:91], v75 offset:8
  s_waitcnt lgkmcnt(11)
  v_mfma_f32_16x16x32_bf16 v[32:35], v[12:15], v[16:19], v[32:35]
  ds_read_b64_tr_b16 v[92:93], v78
  ds_read_b64_tr_b16 v[94:95], v79
  s_waitcnt lgkmcnt(11)
  v_mfma_f32_16x16x32_bf16 v[36:39], v[12:15], v[20:23], v[36:39]
  ds_read_b64_tr_b16 v[96:97], v78 offset:8
  ds_read_b64_tr_b16 v[98:99], v79 offset:8
  s_add_u32 s34, s34, 0x6000
  s_add_u32 s36, s36, 0x800
  s_cmp_eq_u32 s36, 0x3000
  s_cselect_b32 s34, 0, s34
  s_cselect_b32 s36, 0, s36
  s_waitcnt lgkmcnt(11)
  v_mfma_f32_16x16x32_bf16 v[40:43], v[12:15], v[24:27], v[40:43]
  s_waitcnt lgkmcnt(9)
  v_mfma_f32_16x16x32_bf16 v[44:47], v[12:15], v[28:31], v[44:47]
  s_waitcnt lgkmcnt(6)
  v_mfma_f32_16x16x32_bf16 v[32:35], v[80:83], v[84:87], v[32:35]
  s_waitcnt lgkmcnt(4)
  v_mfma_f32_16x16x32_bf16 v[36:39], v[80:83], v[88:91], v[36:39]
  s_waitcnt lgkmcnt(2)
  v_mfma_f32_16x16x32_bf16 v[40:43], v[80:83], v[92:95], v[40:43]
  s_waitcnt lgkmcnt(0)
  v_mfma_f32_16x16x32_bf16 v[44:47], v[80:83], v[96:99], v[44:47]
  v_add_u32 v72, s34, v64
  v_add_u32 v73, s34, v65
  v_add_u32 v74, s34, v66
  v_add_u32 v75, s34, v67
  v_add_u32 v6, s36, v7
  v_xor_b32 v76, 64, v72
  v_xor_b32 v77, 64, v73
  v_xor_b32 v78, 64, v74
  v_xor_b32 v79, 64, v75
  v_xor_b32 v8, 64, v6
  s_bitcmp1_b32 s38, s37
  s_cbranch_scc1 L_vend
  s_add_u32 s37, s37, 1
  s_branch L_v
L_vend:
  s_cmp_eq_u32 s37, 30
  s_cbranch_scc1 L_vdone
  s_waitcnt vmcnt(0)
  s_barrier
  s_bitcmp1_b32 s39, s37
  s_cbranch_scc1 L_vtwo
  s_add_u32 s37, s37, 1
  s_branch L_v
L_vtwo:
  s_add_u32 s37, s37, 1
  s_branch L_vbar
L_vdone:
  s_barrier
  ds_read_b128 v[12:15], v6
  ds_read_b64_tr_b16 v[16:17], v72
  ds_read_b64_tr_b16 v[18:19], v73
  ds_read_b64_tr_b16 v[20:21], v72 offset:8
  ds_read_b64_tr_b16 v[22:23], v73 offset:8
  ds_read_b64_tr_b16 v[24:25], v76
  ds_read_b64_tr_b16 v[26:27], v77
  ds_read_b64_tr_b16 v[28:29], v76 offset:8
  ds_read_b64_tr_b16 v[30:31], v77 offset:8
  s_waitcnt lgkmcnt(6)
  v_mfma_f32_16x16x32_bf16 v[32:35], v[12:15], v[16:19], v[32:35]
  s_waitcnt lgkmcnt(4)
  v_mfma_f32_16x16x32_bf16 v[36:39], v[12:15], v[20:23], v[36:39]
  s_waitcnt lgkmcnt(2)
  v_mfma_f32_16x16x32_bf16 v[40:43], v[12:15], v[24:27], v[40:43]
  s_waitcnt lgkmcnt(0)
  v_mfma_f32_16x16x32_bf16 v[44:47], v[12:15], v[28:31], v[44:47]
  s_barrier
  ds_read_b128 v[80:83], v8
  ds_read_b64_tr_b16 v[84:85], v74
  ds_read_b64_tr_b16 v[86:87], v75
  ds_read_b64_tr_b16 v[88:89], v74 offset:8
  ds_read_b64_tr_b16 v[90:91], v75 offset:8
  ds_read_b64_tr_b16 v[92:93], v78
  ds_read_b64_tr_b16 v[94:95], v79
  ds_read_b64_tr_b16 v[96:97], v78 offset:8
  ds_read_b64_tr_b16 v[98:99], v79 offset:8
  s_waitcnt lgkmcnt(6)
  v_mfma_f32_16x16x32_bf16 v[32:35], v[80:83], v[84:87], v[32:35]
  s_waitcnt lgkmcnt(4)
  v_mfma_f32_16x16x32_bf16 v[36:39], v[80:83], v[88:91], v[36:39]
  s_waitcnt lgkmcnt(2)
  v_mfma_f32_16x16x32_bf16 v[40:43], v[80:83], v[92:95], v[40:43]
  s_waitcnt lgkmcnt(0)
  v_mfma_f32_16x16x32_bf16 v[44:47], v[80:83], v[96:99], v[44:47]
  s_nop 1
  v_cvt_pk_bf16_f32 v48, v32, v33
  v_cvt_pk_bf16_f32 v49, v34, v35
  s_nop 1
  v_mfma_f32_16x16x16_bf16 v[16:19], v[48:49], v[60:61], 0
  v_cvt_pk_bf16_f32 v50, v36, v37
  v_cvt_pk_bf16_f32 v51, v38, v39
  s_nop 1
  v_mfma_f32_16x16x16_bf16 v[20:23], v[50:51], v[60:61], 0
  v_cvt_pk_bf16_f32 v52, v40, v41
  v_cvt_pk_bf16_f32 v53, v42, v43
  s_nop 1
  v_mfma_f32_16x16x16_bf16 v[24:27], v[52:53], v[60:61], 0
  v_cvt_pk_bf16_f32 v54, v44, v45
  v_cvt_pk_bf16_f32 v55, v46, v47
  s_nop 1
  v_mfma_f32_16x16x16_bf16 v[28:31], v[54:55], v[60:61], 0
  v_cvt_pk_bf16_f32 v12, v16, v17
  v_cvt_pk_bf16_f32 v13, v18, v19
  v_cvt_pk_bf16_f32 v14, v20, v21
  v_cvt_pk_bf16_f32 v15, v22, v23
  s_mov_b64 exec, s[46:47]
  s_nop 0
  v_cvt_pk_bf16_f32 v12, v24, v25
  v_cvt_pk_bf16_f32 v13, v26, v27
  v_cvt_pk_bf16_f32 v14, v28, v29
  v_cvt_pk_bf16_f32 v15, v30, v31
  s_mov_b64 exec, -1
  buffer_store_dwordx4 v[12:15], v3, s[28:31], 0 offen
L_end:
  s_endpgm
L_consumer:
  v_add_u32 v1, -1, v1
  s_sub_u32 s3, s3, 1
  s_lshl_b32 s22, s33, 3
  s_add_u32 s22, s22, s3
  s_mov_b32 s32, 0
  s_mov_b32 s33, 0
  s_mov_b32 s18, 65536
  v_lshrrev_b32 v10, 3, v0
  v_and_b32 v12, 7, v0
  v_xor_b32 v13, v12, v11
  v_lshlrev_b32 v13, 4, v13
  v_lshl_add_u32 v68, v10, 12, v13
  v_xor_b32 v69, 0x8040, v68
  s_mul_i32 s41, s2, 3072
  s_mov_b32 s26, 3072
  s_mov_b32 s30, s26
  v_mul_u32_u24 v10, 0x180, v12
  v_lshl_add_u32 v10, v1, 7, v10
  v_lshl_add_u32 v2, v11, 4, v10
  v_and_b32 v10, 8, v0
  v_lshl_add_u32 v3, v10, 3, v2
  s_waitcnt lgkmcnt(0)
  s_call_b64 s[60:61], L_eload
  s_add_u32 s24, s4, s41
  s_addc_u32 s25, s5, 0
  s_add_u32 s28, s66, s41
  s_addc_u32 s29, s67, 0
  s_mov_b32 s27, 0x20000
  s_mov_b32 s31, 0x20000
  buffer_load_dwordx4 v[48:51], v3, s[24:27], 0 offen nt
  v_bfe_u32 v13, v0, 2, 2
  v_lshl_add_u32 v13, v11, 3, v13
  v_mul_u32_u24 v13, 0x180, v13
  v_lshl_add_u32 v13, v1, 7, v13
  v_and_b32 v14, 3, v0
  v_lshlrev_b32 v14, 4, v14
  s_movk_i32 s35, 0x6000
  s_movk_i32 s36, 0x440
  s_movk_i32 s34, 0x600
  s_mov_b32 s38, 4
L_addr:
  v_mov_b32 v64, v65
  v_mov_b32 v65, v66
  v_mov_b32 v66, v67
  v_and_or_b32 v67, v13, s35, v14
  v_bfe_u32 v15, v13, 10, 2
  v_lshl_or_b32 v67, v15, 11, v67
  v_bfe_u32 v15, v13, 8, 2
  v_lshl_or_b32 v67, v15, 7, v67
  v_bfe_u32 v15, v13, 12, 1
  v_lshl_or_b32 v67, v15, 9, v67
  v_lshrrev_b32 v15, 1, v13
  v_xor_b32 v15, v15, v13
  v_bfe_u32 v15, v15, 7, 1
  v_mad_u32_u24 v67, v15, s36, v67
  v_add_u32 v13, s34, v13
  s_xor_b32 s34, s34, 0x2c00
  s_sub_u32 s38, s38, 1
  s_cmp_lg_u32 s38, 0
  s_cbranch_scc1 L_addr
  v_and_b32 v10, 15, v0
  v_lshrrev_b32 v12, 1, v10
  v_xor_b32 v12, v12, v11
  v_lshlrev_b32 v12, 4, v12
  v_lshl_add_u32 v7, v10, 7, v12
  v_add_u32 v7, 147456, v7
  v_lshlrev_b32 v5, 4, v0
  v_add_u32 v5, 159744, v5
  v_lshl_add_u32 v4, v1, 10, v5
  v_mov_b64 v[32:33], 0
  v_mov_b64 v[34:35], 0
  v_mov_b64 v[36:37], 0
  v_mov_b64 v[38:39], 0
  v_mov_b64 v[40:41], 0
  v_mov_b64 v[42:43], 0
  v_mov_b64 v[44:45], 0
  v_mov_b64 v[46:47], 0
  s_mov_b32 s34, 0
  s_mov_b32 s36, 0
  s_mov_b32 s38, 0x92929292
  s_mov_b32 s39, s38
  v_add_u32 v72, s34, v64
  v_add_u32 v73, s34, v65
  v_add_u32 v74, s34, v66
  v_add_u32 v75, s34, v67
  v_add_u32 v6, s36, v7
  v_xor_b32 v76, 64, v72
  v_xor_b32 v77, 64, v73
  v_xor_b32 v78, 64, v74
  v_xor_b32 v79, 64, v75
  v_xor_b32 v8, 64, v6
  s_waitcnt vmcnt(0)
  s_branch L_kbar
.section .rodata,"a"
.p2align 6
.amdhsa_kernel standalone__low_rank_proj_linformer__sampling_kernel
  .amdhsa_next_free_vgpr 104
  .amdhsa_next_free_sgpr 100
  .amdhsa_accum_offset 104
  .amdhsa_group_segment_fixed_size 0
  .amdhsa_kernarg_size 64
  .amdhsa_user_sgpr_count 2
  .amdhsa_user_sgpr_kernarg_segment_ptr 1
  .amdhsa_system_sgpr_workgroup_id_x 1
  .amdhsa_float_denorm_mode_32 3
.end_amdhsa_kernel
```
